```python
import torch

def _softmax(x, axis=-1):
    return torch.softmax(x, dim=axis)

def _gelu(x):
    return torch.nn.functional.gelu(x, approximate='tanh')

def _silu(x):
    return torch.nn.functional.silu(x)

def _sigmoid(x):
    return torch.sigmoid(x)

def _layernorm(x, axis=-1, eps=1e-05):
    m = x.mean(dim=axis, keepdim=True)
    v = x.var(dim=axis, keepdim=True, unbiased=False)
    return (x - m) / torch.sqrt(v + eps)

def _scatter_add(tgt, idx, src, axis=0):
    return tgt.clone().index_add_(axis, idx, src)

def _segment_sum(src, seg, n):
    out = torch.zeros((n,) + src.shape[1:], dtype=src.dtype)
    return out.index_add_(0, seg, src)

def _pad(x, pw):
    flat = tuple((v for pair in reversed(pw) for v in pair))
    return torch.nn.functional.pad(x, flat)
kernel_name = 'standalone__tree_speculative_verify_tree_attention_over_candidate_token_tree__sampling'

def setup_inputs():

    _w = lambda a: (lambda t: t.to(torch.bfloat16) if t.is_floating_point() else t)(torch.as_tensor(a))
    B, Hq, Hkv, T, C, D = (16, 32, 4, 1, 4096, 128)
    tree_mask = torch.zeros((B, T, T), dtype=float)
    for b in range(B):
        parent = torch.zeros(T, dtype=torch.int64)
        for i in range(1, T):
            parent[i] = int(torch.randint(0, i, (1,)).item())
        for i in range(T):
            j = i
            tree_mask[b, i, j] = 1.0
            while j > 0:
                j = parent[j]
                tree_mask[b, i, j] = 1.0
    return {'q': _w((lambda *s: torch.randn(*s, dtype=torch.bfloat16) * 0.8)(B, Hq, T, D)), 'k_cache': _w((lambda *s: torch.randn(*s, dtype=torch.bfloat16) * 0.8)(B, Hkv, C, D)), 'v_cache': _w((lambda *s: torch.randn(*s, dtype=torch.bfloat16) * 0.05)(B, Hkv, C, D)), 'k_tree': _w((lambda *s: torch.randn(*s, dtype=torch.bfloat16) * 0.8)(B, Hkv, T, D)), 'v_tree': _w((lambda *s: torch.randn(*s, dtype=torch.bfloat16) * 0.05)(B, Hkv, T, D)), 'tree_mask': _w(tree_mask)}

def reference(q, k_cache, v_cache, k_tree, v_tree, tree_mask):
    B, Hq, T, D = q.shape
    Hkv, C = (k_cache.shape[1], k_cache.shape[2])
    rep = Hq // Hkv
    kc = (lambda x, n, axis: torch.repeat_interleave(x, n, dim=axis))(k_cache, rep, axis=1)
    vc = (lambda x, n, axis: torch.repeat_interleave(x, n, dim=axis))(v_cache, rep, axis=1)
    kt = (lambda x, n, axis: torch.repeat_interleave(x, n, dim=axis))(k_tree, rep, axis=1)
    vt = (lambda x, n, axis: torch.repeat_interleave(x, n, dim=axis))(v_tree, rep, axis=1)
    k = torch.concatenate([kc, kt], axis=2)
    v = torch.concatenate([vc, vt], axis=2)
    scale = D ** (-0.5)
    scores = torch.einsum('bhqd,bhkd->bhqk', q, k) * scale
    ctx_mask = torch.ones((B, 1, T, C), dtype=scores.dtype)
    tm = tree_mask[:, None, :, :].clone()
    full_mask = torch.concatenate([ctx_mask, tm], axis=-1)
    scores = scores + (1.0 - full_mask) * -1000000000.0
    p = _softmax(scores, axis=-1)
    return torch.einsum('bhqk,bhkd->bhqd', p, v)
```

```asm
; @launch grid=(256,1,1) block=(320,1,1) lds=98560
.amdgcn_target "amdgcn-amd-amdhsa--gfx950"
.text
.globl standalone__tree_speculative_verify_tree_attention_over_candidate_token_tree__sampling_kernel
.p2align 8
.type standalone__tree_speculative_verify_tree_attention_over_candidate_token_tree__sampling_kernel,@function
standalone__tree_speculative_verify_tree_attention_over_candidate_token_tree__sampling_kernel:
  s_load_dwordx16 s[4:19], s[0:1], 0
  s_load_dwordx2 s[20:21], s[0:1], 64
  s_cmp_ge_u32 s2, 256
  s_cbranch_scc1 L_exit
  v_lshrrev_b32 v1, 6, v0
  v_and_b32 v0, 63, v0
  v_readfirstlane_b32 s3, v1
  s_and_b32 s22, s2, 7
  s_lshr_b32 s23, s2, 5
  s_lshl3_add_u32 s22, s22, s23
  s_bfe_u32 s23, s2, 0x20003
  v_lshrrev_b32 v8, 4, v0
  v_and_b32 v9, 15, v0
  s_cmp_lg_u32 s3, 0
  s_cbranch_scc1 L_cons
  s_setprio 3
  v_xor_b32 v1, v9, v8
  v_lshlrev_b32 v1, 4, v1
  v_lshl_add_u32 v1, v8, 8, v1
  v_xor_b32 v2, 64, v1
  v_xor_b32 v3, 0x80, v1
  v_xor_b32 v4, 0xc0, v1
  s_lshl_b32 s56, s22, 20
  s_lshl_b32 s46, s23, 18
  s_mov_b32 s45, s46
  s_mov_b32 s26, 0x100000
  s_mov_b32 s27, 0x20000
  s_mov_b32 m0, 0
  v_lshlrev_b32 v5, 1, v8
  v_xor_b32 v5, v9, v5
  v_lshlrev_b32 v5, 4, v5
  v_lshl_add_u32 v5, v8, 8, v5
  v_xor_b32 v6, 0x80, v5
  s_mov_b32 s44, 0
  s_waitcnt lgkmcnt(0)
  s_add_u32 s24, s6, s56
  s_addc_u32 s25, s7, 0
L_lk:
  s_waitcnt vmcnt(20)
  buffer_load_dwordx4 v1, s[24:27], s46 offen offset:0 nt lds
  s_waitcnt vmcnt(20)
  buffer_load_dwordx4 v2, s[24:27], s46 offen offset:1024 nt lds
  s_waitcnt vmcnt(20)
  buffer_load_dwordx4 v3, s[24:27], s46 offen offset:2048 nt lds
  s_waitcnt vmcnt(20)
  buffer_load_dwordx4 v4, s[24:27], s46 offen offset:3072 nt lds
  s_xor_b32 s46, s46, 0x2000
  s_add_u32 m0, m0, 0x1000
  s_waitcnt vmcnt(20)
  s_cmp_lt_u32 s44, 2
  s_cbranch_scc1 L_nobar
  s_barrier
L_nobar:
  buffer_load_dwordx4 v1, s[24:27], s46 offen offset:0 nt lds
  s_waitcnt vmcnt(20)
  buffer_load_dwordx4 v2, s[24:27], s46 offen offset:1024 nt lds
  s_waitcnt vmcnt(20)
  buffer_load_dwordx4 v3, s[24:27], s46 offen offset:2048 nt lds
  s_waitcnt vmcnt(20)
  buffer_load_dwordx4 v4, s[24:27], s46 offen offset:3072 nt lds
  s_xor_b32 s46, s46, 0x3000
  s_add_u32 m0, m0, 0x1000
  s_waitcnt vmcnt(20)
  buffer_load_dwordx4 v1, s[24:27], s46 offen offset:0 nt lds
  s_waitcnt vmcnt(20)
  buffer_load_dwordx4 v2, s[24:27], s46 offen offset:1024 nt lds
  s_waitcnt vmcnt(20)
  buffer_load_dwordx4 v3, s[24:27], s46 offen offset:2048 nt lds
  s_waitcnt vmcnt(20)
  buffer_load_dwordx4 v4, s[24:27], s46 offen offset:3072 nt lds
  s_xor_b32 s46, s46, 0x2000
  s_add_u32 m0, m0, 0x1000
  s_waitcnt vmcnt(20)
  buffer_load_dwordx4 v1, s[24:27], s46 offen offset:0 nt lds
  s_waitcnt vmcnt(20)
  buffer_load_dwordx4 v2, s[24:27], s46 offen offset:1024 nt lds
  s_waitcnt vmcnt(20)
  buffer_load_dwordx4 v3, s[24:27], s46 offen offset:2048 nt lds
  s_waitcnt vmcnt(20)
  buffer_load_dwordx4 v4, s[24:27], s46 offen offset:3072 nt lds
  s_add_u32 m0, m0, 0x1000
  s_and_b32 m0, m0, 0xffff
  s_add_u32 s44, s44, 1
  s_brev_b32 s47, s44
  s_lshr_b32 s47, s47, 15
  s_and_b32 s47, s47, 0x1c000
  s_and_b32 s48, s44, 8
  s_lshl_b32 s48, s48, 14
  s_or_b32 s46, s45, s47
  s_or_b32 s46, s46, s48
  s_cmp_lt_u32 s44, 16
  s_cbranch_scc1 L_lk
  s_add_u32 s24, s8, s56
  s_addc_u32 s25, s9, 0
L_lv:
  s_waitcnt vmcnt(20)
  buffer_load_dwordx4 v5, s[24:27], s46 offen offset:0 nt lds
  s_waitcnt vmcnt(20)
  buffer_load_dwordx4 v6, s[24:27], s46 offen offset:1024 nt lds
  s_waitcnt vmcnt(20)
  buffer_load_dwordx4 v5, s[24:27], s46 offen offset:2048 nt lds
  s_waitcnt vmcnt(20)
  buffer_load_dwordx4 v6, s[24:27], s46 offen offset:3072 nt lds
  s_xor_b32 s46, s46, 0x2000
  s_add_u32 m0, m0, 0x1000
  s_waitcnt vmcnt(20)
  s_barrier
  buffer_load_dwordx4 v5, s[24:27], s46 offen offset:0 nt lds
  s_waitcnt vmcnt(20)
  buffer_load_dwordx4 v6, s[24:27], s46 offen offset:1024 nt lds
  s_waitcnt vmcnt(20)
  buffer_load_dwordx4 v5, s[24:27], s46 offen offset:2048 nt lds
  s_waitcnt vmcnt(20)
  buffer_load_dwordx4 v6, s[24:27], s46 offen offset:3072 nt lds
  s_xor_b32 s46, s46, 0x3000
  s_add_u32 m0, m0, 0x1000
  s_waitcnt vmcnt(20)
  buffer_load_dwordx4 v5, s[24:27], s46 offen offset:0 nt lds
  s_waitcnt vmcnt(20)
  buffer_load_dwordx4 v6, s[24:27], s46 offen offset:1024 nt lds
  s_waitcnt vmcnt(20)
  buffer_load_dwordx4 v5, s[24:27], s46 offen offset:2048 nt lds
  s_waitcnt vmcnt(20)
  buffer_load_dwordx4 v6, s[24:27], s46 offen offset:3072 nt lds
  s_xor_b32 s46, s46, 0x2000
  s_add_u32 m0, m0, 0x1000
  s_waitcnt vmcnt(20)
  buffer_load_dwordx4 v5, s[24:27], s46 offen offset:0 nt lds
  s_waitcnt vmcnt(20)
  buffer_load_dwordx4 v6, s[24:27], s46 offen offset:1024 nt lds
  s_waitcnt vmcnt(20)
  buffer_load_dwordx4 v5, s[24:27], s46 offen offset:2048 nt lds
  s_waitcnt vmcnt(20)
  buffer_load_dwordx4 v6, s[24:27], s46 offen offset:3072 nt lds
  s_add_u32 m0, m0, 0x1000
  s_and_b32 m0, m0, 0xffff
  s_add_u32 s44, s44, 1
  s_brev_b32 s47, s44
  s_lshr_b32 s47, s47, 15
  s_and_b32 s47, s47, 0x1c000
  s_and_b32 s48, s44, 8
  s_lshl_b32 s48, s48, 14
  s_or_b32 s46, s45, s47
  s_or_b32 s46, s46, s48
  s_cmp_lt_u32 s44, 32
  s_cbranch_scc1 L_lv
  s_waitcnt vmcnt(16)
  s_barrier
  s_waitcnt vmcnt(8)
  s_barrier
  s_waitcnt vmcnt(0)
  s_barrier
  s_endpgm
L_cons:
  s_sub_u32 s3, s3, 1
  v_lshlrev_b32 v91, 4, v0
  s_lshl_b32 s59, s3, 11
  s_add_u32 s59, s59, 90112
  s_lshl_b32 s57, s22, 11
  s_movk_i32 s34, 2048
  s_mov_b32 s35, 0x20000
  s_mov_b32 m0, s59
  v_xor_b32 v1, v8, v9
  v_lshlrev_b32 v1, 4, v1
  v_lshl_add_u32 v1, v9, 8, v1
  s_lshl_b32 s56, s3, 12
  v_add_u32 v1, s56, v1
  v_xor_b32 v2, 64, v1
  v_xor_b32 v3, 0x80, v1
  v_xor_b32 v4, 0xc0, v1
  v_bfe_u32 v5, v0, 2, 4
  v_and_b32 v6, 7, v5
  v_lshlrev_b32 v6, 1, v6
  v_bfe_u32 v7, v0, 1, 1
  s_lshl_b32 s56, s3, 2
  v_add_u32 v7, s56, v7
  v_xor_b32 v6, v6, v7
  v_lshlrev_b32 v6, 4, v6
  v_lshl_add_u32 v5, v5, 8, v6
  v_and_b32 v6, 1, v0
  v_lshl_add_u32 v5, v6, 3, v5
  v_xor_b32 v6, 32, v5
  v_and_b32 v7, 7, v0
  v_lshlrev_b32 v7, 8, v7
  v_lshlrev_b32 v10, 4, v8
  v_lshlrev_b32 v11, 3, v8
  s_lshl_b32 s56, s3, 6
  v_add_u32 v11, s56, v11
  v_bfe_u32 v93, v0, 3, 1
  v_lshl_add_u32 v11, v93, 5, v11
  v_add_u32 v93, v11, v7
  v_add3_u32 v7, v7, v10, s59
  v_and_b32 v0, 0x70, v91
  v_lshl_add_u32 v106, v8, 7, v0
  v_add_u32 v106, 65536, v106
  s_lshl_b32 s56, s3, 9
  v_add_u32 v107, s56, v106
  v_lshlrev_b32 v95, 4, v9
  v_add_u32 v95, 98304, v95
  s_mov_b32 s53, 0x3e0293ee
  s_mov_b32 s54, s53
  s_mov_b32 s55, s53
  v_mov_b32 v88, 0xff800000
  v_mov_b32 v89, 0
  v_mov_b64 v[80:81], 0
  v_mov_b64 v[82:83], 0
  v_mov_b64 v[84:85], 0
  v_mov_b64 v[86:87], 0
  v_mov_b32 v90, 0
  v_mov_b32 v92, 0
  s_waitcnt lgkmcnt(0)
  s_add_u32 s32, s4, s57
  s_addc_u32 s33, s5, 0
  buffer_load_dwordx4 v91, s[32:35], 0 offen lds
  buffer_load_dwordx4 v91, s[32:35], 0 offen offset:1024 lds
  s_lshl_b32 s56, s22, 15
  s_add_u32 s48, s20, s56
  s_addc_u32 s49, s21, 0
  s_mov_b32 s50, 0x8000
  s_mov_b32 s51, 0x20000
  s_mov_b32 s36, s18
  s_mov_b32 s37, s19
  s_movk_i32 s38, 256
  s_mov_b32 s39, 0x20000
  s_lshl_b32 s56, s22, 11
  s_add_u32 s40, s16, s56
  s_addc_u32 s41, s17, 0
  s_movk_i32 s42, 2048
  s_mov_b32 s43, 0x20000
  s_lshl_b32 s57, s3, 13
  s_lshl_b32 s56, s23, 11
  s_add_u32 s60, s56, s57
  s_lshl_b32 s57, s23, 13
  s_add_u32 s56, s23, 1
  s_and_b32 s56, s56, 3
  s_lshl_b32 s56, s56, 11
  s_add_u32 s61, s56, s57
  s_add_u32 s56, s23, 2
  s_and_b32 s56, s56, 3
  s_lshl_b32 s56, s56, 11
  s_add_u32 s62, s56, s57
  s_add_u32 s56, s23, 3
  s_and_b32 s56, s56, 3
  s_lshl_b32 s56, s56, 11
  s_add_u32 s63, s56, s57
  s_add_u32 s24, s20, 0x200000
  s_addc_u32 s25, s21, 0
  s_mov_b32 s26, 0x20000
  s_mov_b32 s27, 0x20000
  s_lshl_b32 s28, s22, 8
  s_lshl3_add_u32 s28, s3, s28
  s_add_u32 s28, s28, 0x10000
  s_getreg_b32 s30, hwreg(HW_REG_XCC_ID, 0, 4)
  s_cmp_eq_u32 s3, s23
  s_cselect_b32 s31, 0, 2
  s_cselect_b32 s29, 7, -1
  s_cselect_b32 s46, 10, -1
  s_xor_b32 s56, s3, 3
  s_or_b32 s56, s56, s2
  s_cselect_b32 s44, -1, 3
  s_cselect_b32 s45, -1, 6
  s_cbranch_scc1 L_notag0
  buffer_load_dword v94, v92, s[24:27], 0 offen sc1
L_notag0:
  s_mov_b32 s58, 0x804944c8
  s_mov_b32 s47, 0
  s_mov_b32 s52, 0
  s_mov_b32 s8, 0x00ff00ff
  s_mov_b32 s9, 0x00ff00ff
  s_barrier
  ds_read_b128 v[40:43], v1
  ds_read_b128 v[44:47], v2
  ds_read_b128 v[48:51], v3
  ds_read_b128 v[52:55], v4
  s_waitcnt vmcnt(0)
  ds_read_b128 v[12:15], v7 offset:0
  ds_read_b128 v[16:19], v7 offset:64
  ds_read_b128 v[20:23], v7 offset:128
  ds_read_b128 v[24:27], v7 offset:192
  s_waitcnt lgkmcnt(0)
  s_branch L_kq
L_kloop:
  s_barrier
  ds_read_b128 v[40:43], v100
  ds_read_b128 v[44:47], v101
  ds_read_b128 v[48:51], v102
  ds_read_b128 v[52:55], v103
L_kq:
  s_waitcnt lgkmcnt(3)
  v_mfma_f32_16x16x32_bf16 v[28:31], v[40:43], v[12:15], 0
  s_waitcnt lgkmcnt(2)
  v_mfma_f32_16x16x32_bf16 v[28:31], v[44:47], v[16:19], v[28:31]
  s_waitcnt lgkmcnt(1)
  v_mfma_f32_16x16x32_bf16 v[28:31], v[48:51], v[20:23], v[28:31]
  s_waitcnt lgkmcnt(0)
  v_mfma_f32_16x16x32_bf16 v[28:31], v[52:55], v[24:27], v[28:31]
  s_add_u32 s52, s52, 0x4000
  s_and_b32 s52, s52, 0xffff
  s_add_u32 s47, s47, 1
  v_add_u32 v100, s52, v1
  v_add_u32 v101, s52, v2
  v_add_u32 v102, s52, v3
  v_add_u32 v103, s52, v4
  s_mov_b64 exec, s[8:9]
  ds_write_b128 v107, v[28:31]
  s_mov_b64 exec, -1
  v_max3_f32 v88, v88, v28, v29
  v_max3_f32 v88, v88, v30, v31
  v_add_u32 v107, 0x800, v107
  s_bitcmp1_b32 s58, s47
  s_cbranch_scc0 L_kloop
  s_cmp_eq_u32 s47, 16
  s_cbranch_scc0 L_events
  v_mul_f32 v88, s53, v88
  s_lshl_b32 s56, s3, 2
  v_mov_b32 v9, v88
  v_add_u32 v8, s56, v95
  v_mov_b32 v104, v5
  v_permlane32_swap_b32 v88, v9
  v_max_f32 v88, v88, v9
  v_mov_b32 v9, v88
  v_mov_b32 v105, v6
  s_nop 0
  v_permlane16_swap_b32 v88, v9
  v_max_f32 v88, v88, v9
  ds_write_b32 v8, v88
  s_waitcnt lgkmcnt(0)
  s_barrier
  ds_read_b128 v[28:31], v95
  ds_read_b128 v[40:43], v106 offset:0
  ds_read_b128 v[44:47], v106 offset:512
  ds_read_b128 v[48:51], v106 offset:1024
  ds_read_b128 v[52:55], v106 offset:1536
  v_add_u32 v106, 0x800, v106
  s_waitcnt lgkmcnt(4)
  v_max3_f32 v88, v28, v29, v30
  v_max_f32 v88, v88, v31
  s_waitcnt lgkmcnt(2)
  v_pk_fma_f32 v[40:41], v[40:41], s[54:55], v[88:89] op_sel_hi:[1,1,0] neg_lo:[0,0,1] neg_hi:[0,0,1]
  v_pk_fma_f32 v[42:43], v[42:43], s[54:55], v[88:89] op_sel_hi:[1,1,0] neg_lo:[0,0,1] neg_hi:[0,0,1]
  v_pk_fma_f32 v[44:45], v[44:45], s[54:55], v[88:89] op_sel_hi:[1,1,0] neg_lo:[0,0,1] neg_hi:[0,0,1]
  v_pk_fma_f32 v[46:47], v[46:47], s[54:55], v[88:89] op_sel_hi:[1,1,0] neg_lo:[0,0,1] neg_hi:[0,0,1]
  v_exp_f32 v40, v40
  v_exp_f32 v41, v41
  v_exp_f32 v42, v42
  v_exp_f32 v43, v43
  v_exp_f32 v44, v44
  v_exp_f32 v45, v45
  v_exp_f32 v46, v46
  v_exp_f32 v47, v47
  v_cvt_pk_bf16_f32 v36, v40, v41
  v_cvt_pk_bf16_f32 v37, v42, v43
  v_cvt_pk_bf16_f32 v38, v44, v45
  v_cvt_pk_bf16_f32 v39, v46, v47
  s_waitcnt lgkmcnt(0)
  v_pk_fma_f32 v[48:49], v[48:49], s[54:55], v[88:89] op_sel_hi:[1,1,0] neg_lo:[0,0,1] neg_hi:[0,0,1]
  v_pk_fma_f32 v[50:51], v[50:51], s[54:55], v[88:89] op_sel_hi:[1,1,0] neg_lo:[0,0,1] neg_hi:[0,0,1]
  v_pk_fma_f32 v[52:53], v[52:53], s[54:55], v[88:89] op_sel_hi:[1,1,0] neg_lo:[0,0,1] neg_hi:[0,0,1]
  v_pk_fma_f32 v[54:55], v[54:55], s[54:55], v[88:89] op_sel_hi:[1,1,0] neg_lo:[0,0,1] neg_hi:[0,0,1]
  v_exp_f32 v48, v48
  v_exp_f32 v49, v49
  v_exp_f32 v50, v50
  v_exp_f32 v51, v51
  v_exp_f32 v52, v52
  v_exp_f32 v53, v53
  v_exp_f32 v54, v54
  v_exp_f32 v55, v55
  v_cvt_pk_bf16_f32 v112, v48, v49
  v_cvt_pk_bf16_f32 v113, v50, v51
  v_cvt_pk_bf16_f32 v114, v52, v53
  v_cvt_pk_bf16_f32 v115, v54, v55
  v_pk_add_f32 v[40:41], v[40:41], v[42:43]
  v_pk_add_f32 v[44:45], v[44:45], v[46:47]
  v_pk_add_f32 v[48:49], v[48:49], v[50:51]
  v_pk_add_f32 v[52:53], v[52:53], v[54:55]
  v_pk_add_f32 v[40:41], v[40:41], v[44:45]
  v_pk_add_f32 v[48:49], v[48:49], v[52:53]
  v_pk_add_f32 v[40:41], v[40:41], v[48:49]
  v_add_f32 v89, v89, v40
  v_add_f32 v89, v89, v41
  s_branch L_vbody
L_vloop:
  s_barrier
L_vbody:
  ds_read_b64_tr_b16 v[72:73], v104 offset:0
  ds_read_b64_tr_b16 v[74:75], v104 offset:4096
  ds_read_b64_tr_b16 v[76:77], v105 offset:0
  ds_read_b64_tr_b16 v[78:79], v105 offset:4096
  ds_read_b64_tr_b16 v[64:65], v104 offset:8192
  ds_read_b64_tr_b16 v[66:67], v104 offset:12288
  ds_read_b64_tr_b16 v[68:69], v105 offset:8192
  ds_read_b64_tr_b16 v[70:71], v105 offset:12288
  ds_read_b128 v[40:43], v106 offset:0
  ds_read_b128 v[44:47], v106 offset:512
  ds_read_b128 v[48:51], v106 offset:1024
  ds_read_b128 v[52:55], v106 offset:1536
  v_add_u32 v106, 0x800, v106
  s_add_u32 s52, s52, 0x4000
  s_and_b32 s52, s52, 0xffff
  s_add_u32 s47, s47, 1
  v_add_u32 v104, s52, v5
  v_add_u32 v105, s52, v6
  s_waitcnt lgkmcnt(10)
  v_mfma_f32_16x16x32_bf16 v[80:83], v[72:75], v[36:39], v[80:83]
  s_waitcnt lgkmcnt(8)
  v_mfma_f32_16x16x32_bf16 v[84:87], v[76:79], v[36:39], v[84:87]
  s_waitcnt lgkmcnt(6)
  v_mfma_f32_16x16x32_bf16 v[80:83], v[64:67], v[112:115], v[80:83]
  s_waitcnt lgkmcnt(4)
  v_mfma_f32_16x16x32_bf16 v[84:87], v[68:71], v[112:115], v[84:87]
  s_waitcnt lgkmcnt(2)
  v_pk_fma_f32 v[40:41], v[40:41], s[54:55], v[88:89] op_sel_hi:[1,1,0] neg_lo:[0,0,1] neg_hi:[0,0,1]
  v_pk_fma_f32 v[42:43], v[42:43], s[54:55], v[88:89] op_sel_hi:[1,1,0] neg_lo:[0,0,1] neg_hi:[0,0,1]
  v_pk_fma_f32 v[44:45], v[44:45], s[54:55], v[88:89] op_sel_hi:[1,1,0] neg_lo:[0,0,1] neg_hi:[0,0,1]
  v_pk_fma_f32 v[46:47], v[46:47], s[54:55], v[88:89] op_sel_hi:[1,1,0] neg_lo:[0,0,1] neg_hi:[0,0,1]
  v_exp_f32 v40, v40
  v_exp_f32 v41, v41
  v_exp_f32 v42, v42
  v_exp_f32 v43, v43
  v_exp_f32 v44, v44
  v_exp_f32 v45, v45
  v_exp_f32 v46, v46
  v_exp_f32 v47, v47
  v_cvt_pk_bf16_f32 v36, v40, v41
  v_cvt_pk_bf16_f32 v37, v42, v43
  v_cvt_pk_bf16_f32 v38, v44, v45
  v_cvt_pk_bf16_f32 v39, v46, v47
  s_waitcnt lgkmcnt(0)
  v_pk_fma_f32 v[48:49], v[48:49], s[54:55], v[88:89] op_sel_hi:[1,1,0] neg_lo:[0,0,1] neg_hi:[0,0,1]
  v_pk_fma_f32 v[50:51], v[50:51], s[54:55], v[88:89] op_sel_hi:[1,1,0] neg_lo:[0,0,1] neg_hi:[0,0,1]
  v_pk_fma_f32 v[52:53], v[52:53], s[54:55], v[88:89] op_sel_hi:[1,1,0] neg_lo:[0,0,1] neg_hi:[0,0,1]
  v_pk_fma_f32 v[54:55], v[54:55], s[54:55], v[88:89] op_sel_hi:[1,1,0] neg_lo:[0,0,1] neg_hi:[0,0,1]
  v_exp_f32 v48, v48
  v_exp_f32 v49, v49
  v_exp_f32 v50, v50
  v_exp_f32 v51, v51
  v_exp_f32 v52, v52
  v_exp_f32 v53, v53
  v_exp_f32 v54, v54
  v_exp_f32 v55, v55
  v_cvt_pk_bf16_f32 v112, v48, v49
  v_cvt_pk_bf16_f32 v113, v50, v51
  v_cvt_pk_bf16_f32 v114, v52, v53
  v_cvt_pk_bf16_f32 v115, v54, v55
  v_pk_add_f32 v[40:41], v[40:41], v[42:43]
  v_pk_add_f32 v[44:45], v[44:45], v[46:47]
  v_pk_add_f32 v[48:49], v[48:49], v[50:51]
  v_pk_add_f32 v[52:53], v[52:53], v[54:55]
  v_pk_add_f32 v[40:41], v[40:41], v[44:45]
  v_pk_add_f32 v[48:49], v[48:49], v[52:53]
  v_pk_add_f32 v[40:41], v[40:41], v[48:49]
  v_add_f32 v89, v89, v40
  v_add_f32 v89, v89, v41
  s_bitcmp1_b32 s58, s47
  s_cbranch_scc0 L_vloop
  s_cmp_eq_u32 s47, 31
  s_cbranch_scc1 L_final
L_events:
  s_cmp_eq_u32 s47, s44
  s_cbranch_scc0 L_not1
  s_waitcnt vmcnt(0)
  v_add_u32 v94, 1, v94
  v_max_u32 v94, 1, v94
  s_mov_b64 exec, 1
  buffer_store_dword v94, v92, s[24:27], 0 offen sc1
  s_mov_b64 exec, -1
L_not1:
  s_cmp_eq_u32 s47, s45
  s_cbranch_scc0 L_not2
  s_waitcnt vmcnt(0)
  s_mov_b64 exec, 1
  buffer_store_dword v94, v92, s[36:39], 0 offen sc1
  s_mov_b64 exec, -1
L_not2:
  s_cmp_eq_u32 s47, s29
  s_cbranch_scc0 L_notr1
  s_lshl_b32 s57, s22, 8
  s_add_u32 s4, s10, s57
  s_addc_u32 s5, s11, 0
  s_movk_i32 s6, 256
  s_mov_b32 s7, 0x20000
  buffer_load_dwordx4 v[56:59], v10, s[4:7], 0 offen offset:0
  buffer_load_dwordx4 v[60:63], v10, s[4:7], 0 offen offset:64
  buffer_load_dwordx4 v[64:67], v10, s[4:7], 0 offen offset:128
  buffer_load_dwordx4 v[68:71], v10, s[4:7], 0 offen offset:192
  s_add_u32 s4, s12, s57
  s_addc_u32 s5, s13, 0
  s_lshr_b32 s57, s22, 2
  buffer_load_dwordx2 v[120:121], v11, s[4:7], 0 offen
  s_mov_b32 s4, s14
  s_mov_b32 s5, s15
  s_movk_i32 s6, 32
  s_lshl_b32 s57, s57, 1
  buffer_load_ushort v122, v92, s[4:7], s57 offen
L_notr1:
  s_cmp_eq_u32 s47, s46
  s_cbranch_scc0 L_notr2
  s_waitcnt vmcnt(0)
  v_mfma_f32_16x16x32_bf16 v[124:127], v[56:59], v[12:15], 0
  v_mfma_f32_16x16x32_bf16 v[124:127], v[60:63], v[16:19], v[124:127]
  v_mfma_f32_16x16x32_bf16 v[124:127], v[64:67], v[20:23], v[124:127]
  v_mfma_f32_16x16x32_bf16 v[124:127], v[68:71], v[24:27], v[124:127]
  v_lshlrev_b32 v122, 16, v122
  v_sub_f32 v122, 1.0, v122
  v_mul_f32 v122, 0xceabfb8f, v122
  v_and_b32 v119, 0xffff0000, v120
  v_lshlrev_b32 v118, 16, v120
  v_lshlrev_b32 v120, 16, v121
  v_and_b32 v121, 0xffff0000, v121
  s_nop 1
  v_fma_f32 v122, v124, s53, v122
L_notr2:
  s_cmp_eq_u32 s47, 10
  s_cbranch_scc0 L_nochk
  buffer_load_dword v90, v92, s[36:39], 0 offen sc1
L_nochk:
  s_cmp_eq_u32 s47, 14
  s_cbranch_scc0 L_tagdone
  s_mov_b32 s57, 0x200000
L_tagspin:
  s_waitcnt vmcnt(0)
  v_readfirstlane_b32 s59, v90
  s_cmp_lg_u32 s59, 0
  s_cbranch_scc1 L_tagok
  buffer_load_dword v90, v92, s[36:39], 0 offen sc1
  s_sub_u32 s57, s57, 1
  s_cbranch_scc0 L_tagspin
L_tagok:
  s_cmp_lg_u32 s31, 0
  s_cbranch_scc1 L_tagdone
  v_mov_b32 v8, v90
  v_mov_b32 v9, s30
  s_mov_b64 exec, 1
  buffer_store_dwordx2 v[8:9], v92, s[24:27], s28 offen sc1
  s_mov_b64 exec, -1
L_tagdone:
  s_cmp_eq_u32 s47, 19
  s_cbranch_scc0 L_nox1
  buffer_load_dwordx2 v[100:101], v92, s[24:27], s28 offen sc1
L_nox1:
  s_cmp_eq_u32 s47, 22
  s_cbranch_scc0 L_nox2
  s_waitcnt vmcnt(0)
  v_readfirstlane_b32 s57, v100
  v_readfirstlane_b32 s56, v101
  s_xor_b32 s57, s57, s59
  s_xor_b32 s56, s56, s30
  s_or_b32 s57, s57, s56
  s_cbranch_scc1 L_nox2
  s_lshr_b32 s31, s31, 1
L_nox2:
  s_cmp_lt_u32 s47, 16
  s_cbranch_scc1 L_kloop
  s_branch L_vloop
L_final:
  v_mov_b32 v9, v89
  v_mov_b32 v108, v88
  v_mov_b32 v99, v90
  v_permlane32_swap_b32 v89, v9
  v_add_f32 v89, v89, v9
  v_mov_b32 v9, v89
  v_mov_b32 v110, v90
  s_mov_b32 s57, 0x200000
  v_permlane16_swap_b32 v89, v9
  v_add_f32 v109, v89, v9
  s_cmp_eq_u32 s31, 1
  s_cbranch_scc0 L_fin2
  s_mov_b64 exec, 0xff
  buffer_store_dwordx4 v[108:111], v0, s[48:51], s60 offen offset:1024
  s_mov_b64 exec, -1
L_fin3:
  s_barrier
  ds_read_b64_tr_b16 v[72:73], v104 offset:0
  ds_read_b64_tr_b16 v[74:75], v104 offset:4096
  ds_read_b64_tr_b16 v[76:77], v105 offset:0
  ds_read_b64_tr_b16 v[78:79], v105 offset:4096
  s_mov_b32 s4, 0x07060501
  s_mov_b32 s5, 0x07060502
  s_mov_b32 s6, 0x07060503
  s_mov_b32 vcc_lo, 0xff00ff00
  s_mov_b32 vcc_hi, 0xff00ff00
  s_cmp_eq_u32 s31, 1
  s_waitcnt lgkmcnt(2)
  v_mfma_f32_16x16x32_bf16 v[80:83], v[72:75], v[36:39], v[80:83]
  s_waitcnt lgkmcnt(0)
  v_mfma_f32_16x16x32_bf16 v[84:87], v[76:79], v[36:39], v[84:87]
  s_barrier
  ds_read_b64_tr_b16 v[64:65], v104 offset:8192
  ds_read_b64_tr_b16 v[66:67], v104 offset:12288
  ds_read_b64_tr_b16 v[68:69], v105 offset:8192
  ds_read_b64_tr_b16 v[70:71], v105 offset:12288
  s_waitcnt lgkmcnt(2)
  v_mfma_f32_16x16x32_bf16 v[80:83], v[64:67], v[112:115], v[80:83]
  s_waitcnt lgkmcnt(0)
  v_mfma_f32_16x16x32_bf16 v[84:87], v[68:71], v[112:115], v[84:87]
  s_nop 7
  v_cndmask_b32 v111, v83, v87, vcc
  v_cndmask_b32 v96, v80, v84, vcc
  v_cndmask_b32 v97, v81, v85, vcc
  v_cndmask_b32 v98, v82, v86, vcc
  s_cbranch_scc0 L_other
  v_perm_b32 v96, v96, v111, s4
  v_perm_b32 v97, v97, v111, s5
  v_perm_b32 v98, v98, v111, s6
  buffer_store_dwordx4 v[96:99], v91, s[48:51], s60 offen
  s_endpgm
L_other:
  s_cmp_eq_u32 s31, 0
  s_cbranch_scc1 L_consume
  v_perm_b32 v96, v96, v111, s4
  v_perm_b32 v97, v97, v111, s5
  v_perm_b32 v98, v98, v111, s6
  buffer_store_dwordx4 v[96:99], v91, s[48:51], s60 offen sc1
  s_endpgm
L_fin2:
  s_cmp_eq_u32 s31, 0
  s_cbranch_scc1 L_fin4
  s_mov_b64 exec, 0xff
  buffer_store_dwordx4 v[108:111], v0, s[48:51], s60 offen offset:1024 sc1
  s_mov_b64 exec, -1
  s_branch L_fin3
L_fin4:
  buffer_load_dwordx4 v[24:27], v0, s[48:51], s61 offen offset:1024 sc1
  buffer_load_dwordx4 v[28:31], v0, s[48:51], s62 offen offset:1024 sc1
  buffer_load_dwordx4 v[32:35], v0, s[48:51], s63 offen offset:1024 sc1
  buffer_load_dwordx4 v[12:15], v91, s[48:51], s61 offen sc1
  buffer_load_dwordx4 v[16:19], v91, s[48:51], s62 offen sc1
  buffer_load_dwordx4 v[20:23], v91, s[48:51], s63 offen sc1
  v_max_f32 v8, v108, v122
  v_sub_f32 v123, v108, v8
  v_sub_f32 v122, v122, v8
  v_exp_f32 v123, v123
  v_exp_f32 v122, v122
  v_mov_b32 v108, v8
  v_fma_f32 v109, v109, v123, v122
  v_mul_f32 v118, v122, v118
  v_mul_f32 v119, v122, v119
  v_mul_f32 v120, v122, v120
  v_mul_f32 v121, v122, v121
  s_branch L_fin3
L_consume:
  v_fma_f32 v96, v96, v123, v118
  v_fma_f32 v97, v97, v123, v119
  v_fma_f32 v98, v98, v123, v120
  v_fma_f32 v99, v111, v123, v121
  s_mov_b32 s4, 0x04000c0c
  s_mov_b32 s5, 0x0706000c
L_spoll:
  s_waitcnt vmcnt(0)
  v_xor_b32 v8, v26, v90
  v_xor_b32 v9, v30, v90
  v_xor_b32 v10, v34, v90
  v_or3_b32 v8, v8, v9, v10
  v_cmp_ne_u32 vcc, 0, v8
  s_cbranch_vccz L_sok
  buffer_load_dwordx4 v[24:27], v0, s[48:51], s61 offen offset:1024 sc1
  buffer_load_dwordx4 v[28:31], v0, s[48:51], s62 offen offset:1024 sc1
  buffer_load_dwordx4 v[32:35], v0, s[48:51], s63 offen offset:1024 sc1
  s_sub_u32 s57, s57, 1
  s_cbranch_scc0 L_spoll
  s_waitcnt vmcnt(0)
L_sok:
  v_xor_b32 v8, v15, v90
  v_xor_b32 v9, v19, v90
  v_xor_b32 v10, v23, v90
  v_or3_b32 v8, v8, v9, v10
  v_cmp_ne_u32 vcc, 0, v8
  s_cbranch_vccz L_noo
  buffer_load_dwordx4 v[12:15], v91, s[48:51], s61 offen sc1
  buffer_load_dwordx4 v[16:19], v91, s[48:51], s62 offen sc1
  buffer_load_dwordx4 v[20:23], v91, s[48:51], s63 offen sc1
L_noo:
  v_max3_f32 v8, v108, v24, v28
  v_max_f32 v8, v8, v32
  v_sub_f32 v108, v108, v8
  v_sub_f32 v24, v24, v8
  v_sub_f32 v28, v28, v8
  v_sub_f32 v32, v32, v8
  v_exp_f32 v108, v108
  v_exp_f32 v24, v24
  v_exp_f32 v28, v28
  v_exp_f32 v32, v32
  v_mul_f32 v109, v108, v109
  v_fmac_f32 v109, v24, v25
  v_fmac_f32 v109, v28, v29
  v_fmac_f32 v109, v32, v33
  v_rcp_f32 v109, v109
  s_mov_b32 s57, 0x200000
  v_mul_f32 v108, v108, v109
  v_mul_f32 v24, v24, v109
  v_mul_f32 v28, v28, v109
  v_mul_f32 v32, v32, v109
  v_pk_mul_f32 v[96:97], v[96:97], v[108:109] op_sel_hi:[1,0]
  v_pk_mul_f32 v[98:99], v[98:99], v[108:109] op_sel_hi:[1,0]
L_opoll:
  s_waitcnt vmcnt(0)
  v_xor_b32 v8, v15, v90
  v_xor_b32 v9, v19, v90
  v_xor_b32 v10, v23, v90
  v_or3_b32 v8, v8, v9, v10
  v_cmp_ne_u32 vcc, 0, v8
  s_cbranch_vccz L_ook
  buffer_load_dwordx4 v[12:15], v91, s[48:51], s61 offen sc1
  buffer_load_dwordx4 v[16:19], v91, s[48:51], s62 offen sc1
  buffer_load_dwordx4 v[20:23], v91, s[48:51], s63 offen sc1
  s_sub_u32 s57, s57, 1
  s_cbranch_scc0 L_opoll
  s_waitcnt vmcnt(0)
L_ook:
  v_perm_b32 v15, v14, v13, s4
  v_perm_b32 v19, v18, v17, s4
  v_perm_b32 v23, v22, v21, s4
  v_pk_fma_f32 v[96:97], v[12:13], v[24:25], v[96:97] op_sel_hi:[1,0,1]
  v_perm_b32 v15, v15, v12, s5
  v_pk_fma_f32 v[96:97], v[16:17], v[28:29], v[96:97] op_sel_hi:[1,0,1]
  v_perm_b32 v19, v19, v16, s5
  v_pk_fma_f32 v[96:97], v[20:21], v[32:33], v[96:97] op_sel_hi:[1,0,1]
  v_perm_b32 v23, v23, v20, s5
  v_pk_fma_f32 v[98:99], v[14:15], v[24:25], v[98:99] op_sel_hi:[1,0,1]
  v_pk_fma_f32 v[98:99], v[18:19], v[28:29], v[98:99] op_sel_hi:[1,0,1]
  v_pk_fma_f32 v[98:99], v[22:23], v[32:33], v[98:99] op_sel_hi:[1,0,1]
  v_cvt_pk_bf16_f32 v96, v96, v97
  v_cvt_pk_bf16_f32 v97, v98, v99
  buffer_store_dwordx2 v[96:97], v93, s[40:43], 0 offen
L_exit:
  s_endpgm
.section .rodata,"a"
.p2align 6
.amdhsa_kernel standalone__tree_speculative_verify_tree_attention_over_candidate_token_tree__sampling_kernel
  .amdhsa_next_free_vgpr 128
  .amdhsa_next_free_sgpr 64
  .amdhsa_accum_offset 128
  .amdhsa_group_segment_fixed_size 0
  .amdhsa_kernarg_size 72
  .amdhsa_user_sgpr_count 2
  .amdhsa_user_sgpr_kernarg_segment_ptr 1
  .amdhsa_system_sgpr_workgroup_id_x 1
.end_amdhsa_kernel
```
